```python
import torch

def _softmax(x, axis=-1):
    return torch.softmax(x, dim=axis)
def _gelu(x):
    return torch.nn.functional.gelu(x, approximate="tanh")
def _silu(x):
    return torch.nn.functional.silu(x)
def _sigmoid(x):
    return torch.sigmoid(x)
def _layernorm(x, axis=-1, eps=1e-5):
    m = x.mean(dim=axis, keepdim=True)
    v = x.var(dim=axis, keepdim=True, unbiased=False)
    return (x - m) / torch.sqrt(v + eps)
def _scatter_add(tgt, idx, src, axis=0):
    return tgt.clone().index_add_(axis, idx, src)
def _segment_sum(src, seg, n):
    out = torch.zeros((n,) + src.shape[1:], dtype=src.dtype)
    return out.index_add_(0, seg, src)
def _pad(x, pw):
    flat = tuple(v for pair in reversed(pw) for v in pair)
    return torch.nn.functional.pad(x, flat)

kernel_name = 'standalone__low_rank_proj_linformer__sampling'

def setup_inputs():

    _w = (lambda a: (lambda t: t.to(torch.bfloat16) if t.is_floating_point() else t)(torch.as_tensor(a)))
    B, H, Sq, Skv, Dh, R = 8, 32, 8, 4096, 128, 16
    return {
        "q": _w((lambda *s: torch.randn(*s, dtype=torch.bfloat16) * 0.8)(B, H, Sq, Dh)),
        "k": _w((lambda *s: torch.randn(*s, dtype=torch.bfloat16) * 0.8)(B, H, Skv, Dh)),
        "v": _w((lambda *s: torch.randn(*s, dtype=torch.bfloat16) * 0.05)(B, H, Skv, Dh)),
        "e_proj": _w((lambda *s: torch.randn(*s, dtype=torch.bfloat16) * 0.8)(R, Skv) * (Skv ** -0.5)),
        "f_proj": _w((lambda *s: torch.randn(*s, dtype=torch.bfloat16) * 0.05)(R, Skv) * (Skv ** -0.5)),
    }

def reference(q, k, v, e_proj, f_proj):
    B, H, Sq, Dh = q.shape
    kp = torch.einsum("rn,bhnd->bhrd", e_proj, k)
    vp = torch.einsum("rn,bhnd->bhrd", f_proj, v)
    scores = torch.einsum("bhqd,bhrd->bhqr", q, kp) * (Dh ** -0.5)
    p = _softmax(scores, axis=-1)
    o = torch.einsum("bhqr,bhrd->bhqd", p, vp)
    return o
```

```asm
; @launch grid=(256,1,1) block=(192,1,1) lds=86016
.amdgcn_target "amdgcn-amd-amdhsa--gfx950"
.text
.globl standalone__low_rank_proj_linformer__sampling_kernel
.p2align 8
.type standalone__low_rank_proj_linformer__sampling_kernel,@function
standalone__low_rank_proj_linformer__sampling_kernel:
    s_load_dwordx16 s[28:43], s[0:1], 0
    s_cmp_ge_u32 s2, 256
    s_cbranch_scc1 L_end
    s_getpc_b64 s[44:45]
L_pc:
    v_lshlrev_b32 v8, 6, v0
    v_min_u32 v8, L_codeend - L_pc - 4, v8
    v_mov_b32 v9, s45
    v_add_co_u32 v8, vcc, s44, v8
    v_readfirstlane_b32 s21, v0
    v_and_b32 v3, 15, v0
    v_addc_co_u32 v9, vcc, 0, v9, vcc
    global_load_dword v63, v[8:9], off
    v_bfe_u32 v4, v0, 4, 2
    v_lshlrev_b32 v7, 12, v4
    v_lshl_add_u32 v1, v3, 4, v7
    v_lshrrev_b32 v7, 7, v7
    v_lshl_add_u32 v2, v3, 13, v7
    s_and_b32 s48, s2, 56
    s_lshr_b32 s48, s48, 2
    s_and_b32 s25, s2, 66
    s_lshr_b32 s25, s25, 1
    s_or_b32 s48, s48, s25
    s_and_b32 s25, s2, 128
    s_or_b32 s48, s48, s25
    s_and_b32 s25, s2, 5
    s_lshl_b32 s25, s25, 4
    s_or_b32 s48, s48, s25
    s_lshr_b32 s21, s21, 6
    s_lshl_b32 s23, s48, 20
    s_lshl_b32 s24, s48, 11
    s_mov_b32 s6, 0x100000
    s_mov_b32 s7, 0x20000
    s_mov_b32 s10, 0x20000
    s_mov_b32 s11, 0x20000
    s_cmp_lg_u32 s21, 2
    s_cbranch_scc1 L_stream
    v_mov_b32 v59, 0
    v_mov_b32 v8, s23
    s_waitcnt lgkmcnt(0)
    global_load_dword v104, v59, s[34:35]
    global_load_dword v105, v59, s[36:37]
    global_load_dword v106, v8, s[32:33]
    global_load_dword v107, v59, s[28:29]
    global_load_dword v108, v59, s[38:39]
    global_load_dword v109, v59, s[42:43]
    s_branch L_helper
L_stream:
    s_mul_i32 s3, s21, 98304
    s_and_b32 s25, s48, 133
    s_bcnt1_i32_b32 s25, s25
    s_bitcmp1_b32 s25, 0
    s_cselect_b32 s25, 2048, 0
    s_xor_b32 s3, s3, s25
    s_and_b32 s25, s48, 32
    s_bcnt1_i32_b32 s25, s25
    s_bitcmp1_b32 s25, 0
    s_cselect_b32 s25, 540672, 0
    s_xor_b32 s3, s3, s25
    s_and_b32 s25, s48, 144
    s_bcnt1_i32_b32 s25, s25
    s_bitcmp1_b32 s25, 0
    s_cselect_b32 s25, 131072, 0
    s_xor_b32 s3, s3, s25
    s_and_b32 s25, s48, 12
    s_bcnt1_i32_b32 s25, s25
    s_bitcmp1_b32 s25, 0
    s_cselect_b32 s25, 262144, 0
    s_xor_b32 s3, s3, s25
    s_mov_b32 s19, s3
    s_lshr_b32 s20, s19, 7
    s_waitcnt lgkmcnt(0)
    s_add_u32 s4, s30, s23
    s_addc_u32 s5, s31, 0
    s_mov_b64 s[8:9], s[34:35]
    buffer_load_dwordx4 v[64:67], v1, s[4:7], s19 offen nt
    buffer_load_dwordx4 v[68:71], v1, s[4:7], s19 offen offset:256 nt
    buffer_load_dwordx4 v[72:75], v1, s[4:7], s19 offen offset:512 nt
    buffer_load_dwordx4 v[76:79], v1, s[4:7], s19 offen offset:768 nt
    buffer_load_dwordx4 v[80:83], v1, s[4:7], s19 offen offset:1024 nt
    buffer_load_dwordx4 v[84:87], v1, s[4:7], s19 offen offset:1280 nt
    buffer_load_dwordx4 v[88:91], v1, s[4:7], s19 offen offset:1536 nt
    buffer_load_dwordx4 v[92:95], v1, s[4:7], s19 offen offset:1792 nt
    buffer_load_dwordx4 v[96:99], v2, s[8:11], s20 offen
    s_xor_b32 s19, s3, 65536
    s_lshr_b32 s20, s19, 7
    buffer_load_dwordx4 v[116:119], v1, s[4:7], s19 offen offset:1024 nt
    buffer_load_dwordx4 v[120:123], v1, s[4:7], s19 offen offset:1280 nt
    buffer_load_dwordx4 v[124:127], v1, s[4:7], s19 offen offset:1536 nt
    buffer_load_dwordx4 v[128:131], v1, s[4:7], s19 offen offset:1792 nt
    buffer_load_dwordx4 v[100:103], v1, s[4:7], s19 offen nt
    buffer_load_dwordx4 v[104:107], v1, s[4:7], s19 offen offset:256 nt
    buffer_load_dwordx4 v[108:111], v1, s[4:7], s19 offen offset:512 nt
    buffer_load_dwordx4 v[112:115], v1, s[4:7], s19 offen offset:768 nt
    buffer_load_dwordx4 v[132:135], v2, s[8:11], s20 offen
    s_xor_b32 s19, s3, 460800
    s_lshr_b32 s20, s19, 7
    buffer_load_dwordx4 v[136:139], v1, s[4:7], s19 offen nt
    buffer_load_dwordx4 v[140:143], v1, s[4:7], s19 offen offset:256 nt
    buffer_load_dwordx4 v[144:147], v1, s[4:7], s19 offen offset:512 nt
    buffer_load_dwordx4 v[148:151], v1, s[4:7], s19 offen offset:768 nt
    buffer_load_dwordx4 v[152:155], v1, s[4:7], s19 offen offset:1024 nt
    buffer_load_dwordx4 v[156:159], v1, s[4:7], s19 offen offset:1280 nt
    buffer_load_dwordx4 v[160:163], v1, s[4:7], s19 offen offset:1536 nt
    buffer_load_dwordx4 v[164:167], v1, s[4:7], s19 offen offset:1792 nt
    buffer_load_dwordx4 v[168:171], v2, s[8:11], s20 offen
    s_xor_b32 s19, s3, 395264
    s_lshr_b32 s20, s19, 7
    s_mov_b32 s16, 0x05040100
    s_mov_b32 s17, 0x07060302
    v_mov_b32 v8, 0
    v_mov_b32 v9, 0
    v_mov_b32 v10, 0
    v_mov_b32 v11, 0
    v_mov_b32 v12, 0
    v_mov_b32 v13, 0
    v_mov_b32 v14, 0
    v_mov_b32 v15, 0
    v_mov_b32 v16, 0
    v_mov_b32 v17, 0
    v_mov_b32 v18, 0
    v_mov_b32 v19, 0
    v_mov_b32 v20, 0
    v_mov_b32 v21, 0
    v_mov_b32 v22, 0
    v_mov_b32 v23, 0
    v_mov_b32 v24, 0
    v_mov_b32 v25, 0
    v_mov_b32 v26, 0
    v_mov_b32 v27, 0
    v_mov_b32 v28, 0
    v_mov_b32 v29, 0
    v_mov_b32 v30, 0
    v_mov_b32 v31, 0
    v_mov_b32 v32, 0
    v_mov_b32 v33, 0
    v_mov_b32 v34, 0
    v_mov_b32 v35, 0
    v_mov_b32 v36, 0
    v_mov_b32 v37, 0
    v_mov_b32 v38, 0
    v_mov_b32 v39, 0
    s_add_u32 s12, s38, s24
    s_addc_u32 s13, s39, 0
    s_mov_b32 s14, 2048
    s_mov_b32 s15, 0x20000
    v_lshlrev_b32 v6, 10, v4
    v_lshl_add_u32 v6, v3, 4, v6
    s_lshl_b32 s25, s21, 3
    v_add_u32 v6, s25, v6
    v_and_b32 v5, 63, v0
    v_lshlrev_b32 v5, 4, v5
    v_mov_b32 v59, 0
    v_mov_b32 v62, s3
    v_bfe_i32 v7, v0, 0, 1
    v_and_b32 v7, 65536, v7
    v_xor_b32 v62, v62, v7
    v_bfe_i32 v7, v0, 1, 1
    v_and_b32 v7, 460800, v7
    v_xor_b32 v62, v62, v7
    v_bfe_i32 v7, v0, 2, 1
    v_and_b32 v7, 393216, v7
    v_xor_b32 v62, v62, v7
    v_bfe_i32 v7, v0, 3, 1
    v_and_b32 v7, 131072, v7
    v_xor_b32 v62, v62, v7
    v_bfe_i32 v7, v0, 4, 1
    v_and_b32 v7, 540672, v7
    v_xor_b32 v62, v62, v7
    v_bfe_i32 v7, v0, 5, 1
    v_and_b32 v7, 16384, v7
    v_xor_b32 v62, v62, v7
    s_mov_b32 s46, 3
    s_mov_b32 s18, 0
    s_mov_b32 s22, 0
    s_mov_b32 s27, 15
    .p2align 6
L_loop:
    s_waitcnt vmcnt(18)
    s_barrier
    s_cmp_lt_u32 s22, 1
    s_cbranch_scc1 L_go0_0
    s_cmp_lt_u32 s22, 2
    s_waitcnt vmcnt(15)
    s_cbranch_scc1 L_go0_0
    s_cmp_lt_u32 s22, 3
    s_waitcnt vmcnt(14)
    s_cbranch_scc1 L_go0_0
    s_cmp_lt_u32 s22, 4
    s_waitcnt vmcnt(13)
    s_cbranch_scc1 L_go0_0
    s_cmp_lt_u32 s22, 5
    s_waitcnt vmcnt(12)
    s_cbranch_scc1 L_go0_0
    s_cmp_lt_u32 s22, 6
    s_waitcnt vmcnt(11)
    s_cbranch_scc1 L_go0_0
    s_cmp_lt_u32 s22, 7
    s_waitcnt vmcnt(10)
    s_cbranch_scc1 L_go0_0
    s_cmp_lt_u32 s22, 8
    s_waitcnt vmcnt(9)
    s_cbranch_scc1 L_go0_0
    s_waitcnt vmcnt(8)
L_go0_0:
    buffer_load_dwordx4 v[204:207], v2, s[8:11], s20 offen
    buffer_load_dwordx4 v[188:191], v1, s[4:7], s19 offen offset:1024 nt
    buffer_load_dwordx4 v[192:195], v1, s[4:7], s19 offen offset:1280 nt
    v_perm_b32 v40, v68, v64, s16
    v_perm_b32 v41, v76, v72, s16
    v_perm_b32 v42, v84, v80, s16
    v_perm_b32 v43, v92, v88, s16
    v_perm_b32 v44, v68, v64, s17
    v_perm_b32 v45, v76, v72, s17
    v_perm_b32 v46, v84, v80, s17
    v_perm_b32 v47, v92, v88, s17
    v_mfma_f32_16x16x32_bf16 v[8:11], v[96:99], v[40:43], v[8:11]
    s_add_u32 s46, s46, 1
    v_mfma_f32_16x16x32_bf16 v[12:15], v[96:99], v[44:47], v[12:15]
    s_cmp_lt_u32 s22, 1
    s_cbranch_scc1 L_go0_1
    s_cmp_lt_u32 s22, 2
    s_waitcnt vmcnt(15)
    s_cbranch_scc1 L_go0_1
    s_cmp_lt_u32 s22, 3
    s_waitcnt vmcnt(14)
    s_cbranch_scc1 L_go0_1
    s_cmp_lt_u32 s22, 4
    s_waitcnt vmcnt(13)
    s_cbranch_scc1 L_go0_1
    s_cmp_lt_u32 s22, 5
    s_waitcnt vmcnt(12)
    s_cbranch_scc1 L_go0_1
    s_cmp_lt_u32 s22, 6
    s_waitcnt vmcnt(11)
    s_cbranch_scc1 L_go0_1
    s_cmp_lt_u32 s22, 7
    s_waitcnt vmcnt(10)
    s_cbranch_scc1 L_go0_1
    s_cmp_lt_u32 s22, 8
    s_waitcnt vmcnt(9)
    s_cbranch_scc1 L_go0_1
    s_waitcnt vmcnt(8)
L_go0_1:
    buffer_load_dwordx4 v[196:199], v1, s[4:7], s19 offen offset:1536 nt
    buffer_load_dwordx4 v[200:203], v1, s[4:7], s19 offen offset:1792 nt
    v_perm_b32 v48, v69, v65, s16
    v_perm_b32 v49, v77, v73, s16
    v_perm_b32 v50, v85, v81, s16
    v_perm_b32 v51, v93, v89, s16
    v_perm_b32 v52, v69, v65, s17
    v_perm_b32 v53, v77, v73, s17
    v_perm_b32 v54, v85, v81, s17
    v_perm_b32 v55, v93, v89, s17
    v_mfma_f32_16x16x32_bf16 v[16:19], v[96:99], v[48:51], v[16:19]
    s_and_b32 s46, s46, 63
    v_mfma_f32_16x16x32_bf16 v[20:23], v[96:99], v[52:55], v[20:23]
    s_cmp_lt_u32 s22, 1
    s_cbranch_scc1 L_go0_2
    s_cmp_lt_u32 s22, 2
    s_waitcnt vmcnt(15)
    s_cbranch_scc1 L_go0_2
    s_cmp_lt_u32 s22, 3
    s_waitcnt vmcnt(14)
    s_cbranch_scc1 L_go0_2
    s_cmp_lt_u32 s22, 4
    s_waitcnt vmcnt(13)
    s_cbranch_scc1 L_go0_2
    s_cmp_lt_u32 s22, 5
    s_waitcnt vmcnt(12)
    s_cbranch_scc1 L_go0_2
    s_cmp_lt_u32 s22, 6
    s_waitcnt vmcnt(11)
    s_cbranch_scc1 L_go0_2
    s_cmp_lt_u32 s22, 7
    s_waitcnt vmcnt(10)
    s_cbranch_scc1 L_go0_2
    s_cmp_lt_u32 s22, 8
    s_waitcnt vmcnt(9)
    s_cbranch_scc1 L_go0_2
    s_waitcnt vmcnt(8)
L_go0_2:
    buffer_load_dwordx4 v[172:175], v1, s[4:7], s19 offen nt
    buffer_load_dwordx4 v[176:179], v1, s[4:7], s19 offen offset:256 nt
    v_perm_b32 v40, v70, v66, s16
    v_perm_b32 v41, v78, v74, s16
    v_perm_b32 v42, v86, v82, s16
    v_perm_b32 v43, v94, v90, s16
    v_perm_b32 v44, v70, v66, s17
    v_perm_b32 v45, v78, v74, s17
    v_perm_b32 v46, v86, v82, s17
    v_perm_b32 v47, v94, v90, s17
    v_mfma_f32_16x16x32_bf16 v[24:27], v[96:99], v[40:43], v[24:27]
    v_readlane_b32 s49, v62, s46
    v_mfma_f32_16x16x32_bf16 v[28:31], v[96:99], v[44:47], v[28:31]
    s_cmp_lt_u32 s22, 1
    s_cbranch_scc1 L_go0_3
    s_cmp_lt_u32 s22, 2
    s_waitcnt vmcnt(15)
    s_cbranch_scc1 L_go0_3
    s_cmp_lt_u32 s22, 3
    s_waitcnt vmcnt(14)
    s_cbranch_scc1 L_go0_3
    s_cmp_lt_u32 s22, 4
    s_waitcnt vmcnt(13)
    s_cbranch_scc1 L_go0_3
    s_cmp_lt_u32 s22, 5
    s_waitcnt vmcnt(12)
    s_cbranch_scc1 L_go0_3
    s_cmp_lt_u32 s22, 6
    s_waitcnt vmcnt(11)
    s_cbranch_scc1 L_go0_3
    s_cmp_lt_u32 s22, 7
    s_waitcnt vmcnt(10)
    s_cbranch_scc1 L_go0_3
    s_cmp_lt_u32 s22, 8
    s_waitcnt vmcnt(9)
    s_cbranch_scc1 L_go0_3
    s_waitcnt vmcnt(8)
L_go0_3:
    buffer_load_dwordx4 v[180:183], v1, s[4:7], s19 offen offset:512 nt
    buffer_load_dwordx4 v[184:187], v1, s[4:7], s19 offen offset:768 nt
    ds_read_b32 v58, v59 offset:25088
    v_perm_b32 v48, v71, v67, s16
    v_perm_b32 v49, v79, v75, s16
    v_perm_b32 v50, v87, v83, s16
    v_perm_b32 v51, v95, v91, s16
    v_perm_b32 v52, v71, v67, s17
    v_perm_b32 v53, v79, v75, s17
    v_perm_b32 v54, v87, v83, s17
    v_perm_b32 v55, v95, v91, s17
    v_mfma_f32_16x16x32_bf16 v[32:35], v[96:99], v[48:51], v[32:35]
    s_lshr_b32 s53, s49, 7
    v_mfma_f32_16x16x32_bf16 v[36:39], v[96:99], v[52:55], v[36:39]
    s_waitcnt lgkmcnt(0)
    v_readfirstlane_b32 s22, v58
    s_min_u32 s22, s22, s27
    s_and_b32 s25, s18, 15
    s_cmp_eq_u32 s25, 15
    s_cbranch_scc1 L_switch
L_swret:
    s_waitcnt vmcnt(18)
    s_barrier
    s_cmp_lt_u32 s22, 1
    s_cbranch_scc1 L_go1_0
    s_cmp_lt_u32 s22, 2
    s_waitcnt vmcnt(15)
    s_cbranch_scc1 L_go1_0
    s_cmp_lt_u32 s22, 3
    s_waitcnt vmcnt(14)
    s_cbranch_scc1 L_go1_0
    s_cmp_lt_u32 s22, 4
    s_waitcnt vmcnt(13)
    s_cbranch_scc1 L_go1_0
    s_cmp_lt_u32 s22, 5
    s_waitcnt vmcnt(12)
    s_cbranch_scc1 L_go1_0
    s_cmp_lt_u32 s22, 6
    s_waitcnt vmcnt(11)
    s_cbranch_scc1 L_go1_0
    s_cmp_lt_u32 s22, 7
    s_waitcnt vmcnt(10)
    s_cbranch_scc1 L_go1_0
    s_cmp_lt_u32 s22, 8
    s_waitcnt vmcnt(9)
    s_cbranch_scc1 L_go1_0
    s_waitcnt vmcnt(8)
L_go1_0:
    buffer_load_dwordx4 v[96:99], v2, s[8:11], s53 offen
    buffer_load_dwordx4 v[64:67], v1, s[4:7], s49 offen nt
    buffer_load_dwordx4 v[68:71], v1, s[4:7], s49 offen offset:256 nt
    v_perm_b32 v40, v104, v100, s16
    v_perm_b32 v41, v112, v108, s16
    v_perm_b32 v42, v120, v116, s16
    v_perm_b32 v43, v128, v124, s16
    v_perm_b32 v44, v104, v100, s17
    v_perm_b32 v45, v112, v108, s17
    v_perm_b32 v46, v120, v116, s17
    v_perm_b32 v47, v128, v124, s17
    v_mfma_f32_16x16x32_bf16 v[8:11], v[132:135], v[40:43], v[8:11]
    s_add_u32 s46, s46, 1
    v_mfma_f32_16x16x32_bf16 v[12:15], v[132:135], v[44:47], v[12:15]
    s_cmp_lt_u32 s22, 1
    s_cbranch_scc1 L_go1_1
    s_cmp_lt_u32 s22, 2
    s_waitcnt vmcnt(15)
    s_cbranch_scc1 L_go1_1
    s_cmp_lt_u32 s22, 3
    s_waitcnt vmcnt(14)
    s_cbranch_scc1 L_go1_1
    s_cmp_lt_u32 s22, 4
    s_waitcnt vmcnt(13)
    s_cbranch_scc1 L_go1_1
    s_cmp_lt_u32 s22, 5
    s_waitcnt vmcnt(12)
    s_cbranch_scc1 L_go1_1
    s_cmp_lt_u32 s22, 6
    s_waitcnt vmcnt(11)
    s_cbranch_scc1 L_go1_1
    s_cmp_lt_u32 s22, 7
    s_waitcnt vmcnt(10)
    s_cbranch_scc1 L_go1_1
    s_cmp_lt_u32 s22, 8
    s_waitcnt vmcnt(9)
    s_cbranch_scc1 L_go1_1
    s_waitcnt vmcnt(8)
L_go1_1:
    buffer_load_dwordx4 v[72:75], v1, s[4:7], s49 offen offset:512 nt
    buffer_load_dwordx4 v[76:79], v1, s[4:7], s49 offen offset:768 nt
    v_perm_b32 v48, v105, v101, s16
    v_perm_b32 v49, v113, v109, s16
    v_perm_b32 v50, v121, v117, s16
    v_perm_b32 v51, v129, v125, s16
    v_perm_b32 v52, v105, v101, s17
    v_perm_b32 v53, v113, v109, s17
    v_perm_b32 v54, v121, v117, s17
    v_perm_b32 v55, v129, v125, s17
    v_mfma_f32_16x16x32_bf16 v[16:19], v[132:135], v[48:51], v[16:19]
    s_and_b32 s46, s46, 63
    v_mfma_f32_16x16x32_bf16 v[20:23], v[132:135], v[52:55], v[20:23]
    s_cmp_lt_u32 s22, 1
    s_cbranch_scc1 L_go1_2
    s_cmp_lt_u32 s22, 2
    s_waitcnt vmcnt(15)
    s_cbranch_scc1 L_go1_2
    s_cmp_lt_u32 s22, 3
    s_waitcnt vmcnt(14)
    s_cbranch_scc1 L_go1_2
    s_cmp_lt_u32 s22, 4
    s_waitcnt vmcnt(13)
    s_cbranch_scc1 L_go1_2
    s_cmp_lt_u32 s22, 5
    s_waitcnt vmcnt(12)
    s_cbranch_scc1 L_go1_2
    s_cmp_lt_u32 s22, 6
    s_waitcnt vmcnt(11)
    s_cbranch_scc1 L_go1_2
    s_cmp_lt_u32 s22, 7
    s_waitcnt vmcnt(10)
    s_cbranch_scc1 L_go1_2
    s_cmp_lt_u32 s22, 8
    s_waitcnt vmcnt(9)
    s_cbranch_scc1 L_go1_2
    s_waitcnt vmcnt(8)
L_go1_2:
    buffer_load_dwordx4 v[80:83], v1, s[4:7], s49 offen offset:1024 nt
    buffer_load_dwordx4 v[84:87], v1, s[4:7], s49 offen offset:1280 nt
    v_perm_b32 v40, v106, v102, s16
    v_perm_b32 v41, v114, v110, s16
    v_perm_b32 v42, v122, v118, s16
    v_perm_b32 v43, v130, v126, s16
    v_perm_b32 v44, v106, v102, s17
    v_perm_b32 v45, v114, v110, s17
    v_perm_b32 v46, v122, v118, s17
    v_perm_b32 v47, v130, v126, s17
    v_mfma_f32_16x16x32_bf16 v[24:27], v[132:135], v[40:43], v[24:27]
    v_readlane_b32 s19, v62, s46
    v_mfma_f32_16x16x32_bf16 v[28:31], v[132:135], v[44:47], v[28:31]
    s_cmp_lt_u32 s22, 1
    s_cbranch_scc1 L_go1_3
    s_cmp_lt_u32 s22, 2
    s_waitcnt vmcnt(15)
    s_cbranch_scc1 L_go1_3
    s_cmp_lt_u32 s22, 3
    s_waitcnt vmcnt(14)
    s_cbranch_scc1 L_go1_3
    s_cmp_lt_u32 s22, 4
    s_waitcnt vmcnt(13)
    s_cbranch_scc1 L_go1_3
    s_cmp_lt_u32 s22, 5
    s_waitcnt vmcnt(12)
    s_cbranch_scc1 L_go1_3
    s_cmp_lt_u32 s22, 6
    s_waitcnt vmcnt(11)
    s_cbranch_scc1 L_go1_3
    s_cmp_lt_u32 s22, 7
    s_waitcnt vmcnt(10)
    s_cbranch_scc1 L_go1_3
    s_cmp_lt_u32 s22, 8
    s_waitcnt vmcnt(9)
    s_cbranch_scc1 L_go1_3
    s_waitcnt vmcnt(8)
L_go1_3:
    buffer_load_dwordx4 v[88:91], v1, s[4:7], s49 offen offset:1536 nt
    buffer_load_dwordx4 v[92:95], v1, s[4:7], s49 offen offset:1792 nt
    ds_read_b32 v58, v59 offset:25088
    v_perm_b32 v48, v107, v103, s16
    v_perm_b32 v49, v115, v111, s16
    v_perm_b32 v50, v123, v119, s16
    v_perm_b32 v51, v131, v127, s16
    v_perm_b32 v52, v107, v103, s17
    v_perm_b32 v53, v115, v111, s17
    v_perm_b32 v54, v123, v119, s17
    v_perm_b32 v55, v131, v127, s17
    v_mfma_f32_16x16x32_bf16 v[32:35], v[132:135], v[48:51], v[32:35]
    s_lshr_b32 s20, s19, 7
    v_mfma_f32_16x16x32_bf16 v[36:39], v[132:135], v[52:55], v[36:39]
    s_waitcnt lgkmcnt(0)
    v_readfirstlane_b32 s22, v58
    s_min_u32 s22, s22, s27
    s_waitcnt vmcnt(18)
    s_barrier
    s_cmp_lt_u32 s22, 1
    s_cbranch_scc1 L_go2_0
    s_cmp_lt_u32 s22, 2
    s_waitcnt vmcnt(15)
    s_cbranch_scc1 L_go2_0
    s_cmp_lt_u32 s22, 3
    s_waitcnt vmcnt(14)
    s_cbranch_scc1 L_go2_0
    s_cmp_lt_u32 s22, 4
    s_waitcnt vmcnt(13)
    s_cbranch_scc1 L_go2_0
    s_cmp_lt_u32 s22, 5
    s_waitcnt vmcnt(12)
    s_cbranch_scc1 L_go2_0
    s_cmp_lt_u32 s22, 6
    s_waitcnt vmcnt(11)
    s_cbranch_scc1 L_go2_0
    s_cmp_lt_u32 s22, 7
    s_waitcnt vmcnt(10)
    s_cbranch_scc1 L_go2_0
    s_cmp_lt_u32 s22, 8
    s_waitcnt vmcnt(9)
    s_cbranch_scc1 L_go2_0
    s_waitcnt vmcnt(8)
L_go2_0:
    buffer_load_dwordx4 v[132:135], v2, s[8:11], s20 offen
    buffer_load_dwordx4 v[116:119], v1, s[4:7], s19 offen offset:1024 nt
    buffer_load_dwordx4 v[120:123], v1, s[4:7], s19 offen offset:1280 nt
    v_perm_b32 v40, v140, v136, s16
    v_perm_b32 v41, v148, v144, s16
    v_perm_b32 v42, v156, v152, s16
    v_perm_b32 v43, v164, v160, s16
    v_perm_b32 v44, v140, v136, s17
    v_perm_b32 v45, v148, v144, s17
    v_perm_b32 v46, v156, v152, s17
    v_perm_b32 v47, v164, v160, s17
    v_mfma_f32_16x16x32_bf16 v[8:11], v[168:171], v[40:43], v[8:11]
    s_add_u32 s46, s46, 1
    v_mfma_f32_16x16x32_bf16 v[12:15], v[168:171], v[44:47], v[12:15]
    s_cmp_lt_u32 s22, 1
    s_cbranch_scc1 L_go2_1
    s_cmp_lt_u32 s22, 2
    s_waitcnt vmcnt(15)
    s_cbranch_scc1 L_go2_1
    s_cmp_lt_u32 s22, 3
    s_waitcnt vmcnt(14)
    s_cbranch_scc1 L_go2_1
    s_cmp_lt_u32 s22, 4
    s_waitcnt vmcnt(13)
    s_cbranch_scc1 L_go2_1
    s_cmp_lt_u32 s22, 5
    s_waitcnt vmcnt(12)
    s_cbranch_scc1 L_go2_1
    s_cmp_lt_u32 s22, 6
    s_waitcnt vmcnt(11)
    s_cbranch_scc1 L_go2_1
    s_cmp_lt_u32 s22, 7
    s_waitcnt vmcnt(10)
    s_cbranch_scc1 L_go2_1
    s_cmp_lt_u32 s22, 8
    s_waitcnt vmcnt(9)
    s_cbranch_scc1 L_go2_1
    s_waitcnt vmcnt(8)
L_go2_1:
    buffer_load_dwordx4 v[124:127], v1, s[4:7], s19 offen offset:1536 nt
    buffer_load_dwordx4 v[128:131], v1, s[4:7], s19 offen offset:1792 nt
    v_perm_b32 v48, v141, v137, s16
    v_perm_b32 v49, v149, v145, s16
    v_perm_b32 v50, v157, v153, s16
    v_perm_b32 v51, v165, v161, s16
    v_perm_b32 v52, v141, v137, s17
    v_perm_b32 v53, v149, v145, s17
    v_perm_b32 v54, v157, v153, s17
    v_perm_b32 v55, v165, v161, s17
    v_mfma_f32_16x16x32_bf16 v[16:19], v[168:171], v[48:51], v[16:19]
    s_and_b32 s46, s46, 63
    v_mfma_f32_16x16x32_bf16 v[20:23], v[168:171], v[52:55], v[20:23]
    s_cmp_lt_u32 s22, 1
    s_cbranch_scc1 L_go2_2
    s_cmp_lt_u32 s22, 2
    s_waitcnt vmcnt(15)
    s_cbranch_scc1 L_go2_2
    s_cmp_lt_u32 s22, 3
    s_waitcnt vmcnt(14)
    s_cbranch_scc1 L_go2_2
    s_cmp_lt_u32 s22, 4
    s_waitcnt vmcnt(13)
    s_cbranch_scc1 L_go2_2
    s_cmp_lt_u32 s22, 5
    s_waitcnt vmcnt(12)
    s_cbranch_scc1 L_go2_2
    s_cmp_lt_u32 s22, 6
    s_waitcnt vmcnt(11)
    s_cbranch_scc1 L_go2_2
    s_cmp_lt_u32 s22, 7
    s_waitcnt vmcnt(10)
    s_cbranch_scc1 L_go2_2
    s_cmp_lt_u32 s22, 8
    s_waitcnt vmcnt(9)
    s_cbranch_scc1 L_go2_2
    s_waitcnt vmcnt(8)
L_go2_2:
    buffer_load_dwordx4 v[100:103], v1, s[4:7], s19 offen nt
    buffer_load_dwordx4 v[104:107], v1, s[4:7], s19 offen offset:256 nt
    v_perm_b32 v40, v142, v138, s16
    v_perm_b32 v41, v150, v146, s16
    v_perm_b32 v42, v158, v154, s16
    v_perm_b32 v43, v166, v162, s16
    v_perm_b32 v44, v142, v138, s17
    v_perm_b32 v45, v150, v146, s17
    v_perm_b32 v46, v158, v154, s17
    v_perm_b32 v47, v166, v162, s17
    v_mfma_f32_16x16x32_bf16 v[24:27], v[168:171], v[40:43], v[24:27]
    v_readlane_b32 s49, v62, s46
    v_mfma_f32_16x16x32_bf16 v[28:31], v[168:171], v[44:47], v[28:31]
    s_cmp_lt_u32 s22, 1
    s_cbranch_scc1 L_go2_3
    s_cmp_lt_u32 s22, 2
    s_waitcnt vmcnt(15)
    s_cbranch_scc1 L_go2_3
    s_cmp_lt_u32 s22, 3
    s_waitcnt vmcnt(14)
    s_cbranch_scc1 L_go2_3
    s_cmp_lt_u32 s22, 4
    s_waitcnt vmcnt(13)
    s_cbranch_scc1 L_go2_3
    s_cmp_lt_u32 s22, 5
    s_waitcnt vmcnt(12)
    s_cbranch_scc1 L_go2_3
    s_cmp_lt_u32 s22, 6
    s_waitcnt vmcnt(11)
    s_cbranch_scc1 L_go2_3
    s_cmp_lt_u32 s22, 7
    s_waitcnt vmcnt(10)
    s_cbranch_scc1 L_go2_3
    s_cmp_lt_u32 s22, 8
    s_waitcnt vmcnt(9)
    s_cbranch_scc1 L_go2_3
    s_waitcnt vmcnt(8)
L_go2_3:
    buffer_load_dwordx4 v[108:111], v1, s[4:7], s19 offen offset:512 nt
    buffer_load_dwordx4 v[112:115], v1, s[4:7], s19 offen offset:768 nt
    ds_read_b32 v58, v59 offset:25088
    v_perm_b32 v48, v143, v139, s16
    v_perm_b32 v49, v151, v147, s16
    v_perm_b32 v50, v159, v155, s16
    v_perm_b32 v51, v167, v163, s16
    v_perm_b32 v52, v143, v139, s17
    v_perm_b32 v53, v151, v147, s17
    v_perm_b32 v54, v159, v155, s17
    v_perm_b32 v55, v167, v163, s17
    v_mfma_f32_16x16x32_bf16 v[32:35], v[168:171], v[48:51], v[32:35]
    s_lshr_b32 s53, s49, 7
    v_mfma_f32_16x16x32_bf16 v[36:39], v[168:171], v[52:55], v[36:39]
    s_waitcnt lgkmcnt(0)
    v_readfirstlane_b32 s22, v58
    s_min_u32 s22, s22, s27
    s_cmp_eq_u32 s18, 31
    s_cbranch_scc1 L_tail
    s_cmp_eq_u32 s18, 15
    s_cselect_b32 s22, 1, s22
    s_waitcnt vmcnt(18)
    s_barrier
    s_cmp_lt_u32 s22, 1
    s_cbranch_scc1 L_go3_0
    s_cmp_lt_u32 s22, 2
    s_waitcnt vmcnt(15)
    s_cbranch_scc1 L_go3_0
    s_cmp_lt_u32 s22, 3
    s_waitcnt vmcnt(14)
    s_cbranch_scc1 L_go3_0
    s_cmp_lt_u32 s22, 4
    s_waitcnt vmcnt(13)
    s_cbranch_scc1 L_go3_0
    s_cmp_lt_u32 s22, 5
    s_waitcnt vmcnt(12)
    s_cbranch_scc1 L_go3_0
    s_cmp_lt_u32 s22, 6
    s_waitcnt vmcnt(11)
    s_cbranch_scc1 L_go3_0
    s_cmp_lt_u32 s22, 7
    s_waitcnt vmcnt(10)
    s_cbranch_scc1 L_go3_0
    s_cmp_lt_u32 s22, 8
    s_waitcnt vmcnt(9)
    s_cbranch_scc1 L_go3_0
    s_waitcnt vmcnt(8)
L_go3_0:
    buffer_load_dwordx4 v[168:171], v2, s[8:11], s53 offen
    buffer_load_dwordx4 v[136:139], v1, s[4:7], s49 offen nt
    buffer_load_dwordx4 v[140:143], v1, s[4:7], s49 offen offset:256 nt
    v_perm_b32 v40, v176, v172, s16
    v_perm_b32 v41, v184, v180, s16
    v_perm_b32 v42, v192, v188, s16
    v_perm_b32 v43, v200, v196, s16
    v_perm_b32 v44, v176, v172, s17
    v_perm_b32 v45, v184, v180, s17
    v_perm_b32 v46, v192, v188, s17
    v_perm_b32 v47, v200, v196, s17
    v_mfma_f32_16x16x32_bf16 v[8:11], v[204:207], v[40:43], v[8:11]
    s_add_u32 s46, s46, 1
    v_mfma_f32_16x16x32_bf16 v[12:15], v[204:207], v[44:47], v[12:15]
    s_cmp_lt_u32 s22, 1
    s_cbranch_scc1 L_go3_1
    s_cmp_lt_u32 s22, 2
    s_waitcnt vmcnt(15)
    s_cbranch_scc1 L_go3_1
    s_cmp_lt_u32 s22, 3
    s_waitcnt vmcnt(14)
    s_cbranch_scc1 L_go3_1
    s_cmp_lt_u32 s22, 4
    s_waitcnt vmcnt(13)
    s_cbranch_scc1 L_go3_1
    s_cmp_lt_u32 s22, 5
    s_waitcnt vmcnt(12)
    s_cbranch_scc1 L_go3_1
    s_cmp_lt_u32 s22, 6
    s_waitcnt vmcnt(11)
    s_cbranch_scc1 L_go3_1
    s_cmp_lt_u32 s22, 7
    s_waitcnt vmcnt(10)
    s_cbranch_scc1 L_go3_1
    s_cmp_lt_u32 s22, 8
    s_waitcnt vmcnt(9)
    s_cbranch_scc1 L_go3_1
    s_waitcnt vmcnt(8)
L_go3_1:
    buffer_load_dwordx4 v[144:147], v1, s[4:7], s49 offen offset:512 nt
    buffer_load_dwordx4 v[148:151], v1, s[4:7], s49 offen offset:768 nt
    v_perm_b32 v48, v177, v173, s16
    v_perm_b32 v49, v185, v181, s16
    v_perm_b32 v50, v193, v189, s16
    v_perm_b32 v51, v201, v197, s16
    v_perm_b32 v52, v177, v173, s17
    v_perm_b32 v53, v185, v181, s17
    v_perm_b32 v54, v193, v189, s17
    v_perm_b32 v55, v201, v197, s17
    v_mfma_f32_16x16x32_bf16 v[16:19], v[204:207], v[48:51], v[16:19]
    s_and_b32 s46, s46, 63
    v_mfma_f32_16x16x32_bf16 v[20:23], v[204:207], v[52:55], v[20:23]
    s_cmp_lt_u32 s22, 1
    s_cbranch_scc1 L_go3_2
    s_cmp_lt_u32 s22, 2
    s_waitcnt vmcnt(15)
    s_cbranch_scc1 L_go3_2
    s_cmp_lt_u32 s22, 3
    s_waitcnt vmcnt(14)
    s_cbranch_scc1 L_go3_2
    s_cmp_lt_u32 s22, 4
    s_waitcnt vmcnt(13)
    s_cbranch_scc1 L_go3_2
    s_cmp_lt_u32 s22, 5
    s_waitcnt vmcnt(12)
    s_cbranch_scc1 L_go3_2
    s_cmp_lt_u32 s22, 6
    s_waitcnt vmcnt(11)
    s_cbranch_scc1 L_go3_2
    s_cmp_lt_u32 s22, 7
    s_waitcnt vmcnt(10)
    s_cbranch_scc1 L_go3_2
    s_cmp_lt_u32 s22, 8
    s_waitcnt vmcnt(9)
    s_cbranch_scc1 L_go3_2
    s_waitcnt vmcnt(8)
L_go3_2:
    buffer_load_dwordx4 v[152:155], v1, s[4:7], s49 offen offset:1024 nt
    buffer_load_dwordx4 v[156:159], v1, s[4:7], s49 offen offset:1280 nt
    v_perm_b32 v40, v178, v174, s16
    v_perm_b32 v41, v186, v182, s16
    v_perm_b32 v42, v194, v190, s16
    v_perm_b32 v43, v202, v198, s16
    v_perm_b32 v44, v178, v174, s17
    v_perm_b32 v45, v186, v182, s17
    v_perm_b32 v46, v194, v190, s17
    v_perm_b32 v47, v202, v198, s17
    v_mfma_f32_16x16x32_bf16 v[24:27], v[204:207], v[40:43], v[24:27]
    v_readlane_b32 s19, v62, s46
    v_mfma_f32_16x16x32_bf16 v[28:31], v[204:207], v[44:47], v[28:31]
    s_cmp_lt_u32 s22, 1
    s_cbranch_scc1 L_go3_3
    s_cmp_lt_u32 s22, 2
    s_waitcnt vmcnt(15)
    s_cbranch_scc1 L_go3_3
    s_cmp_lt_u32 s22, 3
    s_waitcnt vmcnt(14)
    s_cbranch_scc1 L_go3_3
    s_cmp_lt_u32 s22, 4
    s_waitcnt vmcnt(13)
    s_cbranch_scc1 L_go3_3
    s_cmp_lt_u32 s22, 5
    s_waitcnt vmcnt(12)
    s_cbranch_scc1 L_go3_3
    s_cmp_lt_u32 s22, 6
    s_waitcnt vmcnt(11)
    s_cbranch_scc1 L_go3_3
    s_cmp_lt_u32 s22, 7
    s_waitcnt vmcnt(10)
    s_cbranch_scc1 L_go3_3
    s_cmp_lt_u32 s22, 8
    s_waitcnt vmcnt(9)
    s_cbranch_scc1 L_go3_3
    s_waitcnt vmcnt(8)
L_go3_3:
    buffer_load_dwordx4 v[160:163], v1, s[4:7], s49 offen offset:1536 nt
    buffer_load_dwordx4 v[164:167], v1, s[4:7], s49 offen offset:1792 nt
    ds_read_b32 v58, v59 offset:25088
    v_perm_b32 v48, v179, v175, s16
    v_perm_b32 v49, v187, v183, s16
    v_perm_b32 v50, v195, v191, s16
    v_perm_b32 v51, v203, v199, s16
    v_perm_b32 v52, v179, v175, s17
    v_perm_b32 v53, v187, v183, s17
    v_perm_b32 v54, v195, v191, s17
    v_perm_b32 v55, v203, v199, s17
    v_mfma_f32_16x16x32_bf16 v[32:35], v[204:207], v[48:51], v[32:35]
    s_lshr_b32 s20, s19, 7
    v_mfma_f32_16x16x32_bf16 v[36:39], v[204:207], v[52:55], v[36:39]
    s_add_u32 s18, s18, 1
    s_waitcnt lgkmcnt(0)
    v_readfirstlane_b32 s22, v58
    s_min_u32 s22, s22, s27
    s_cmp_eq_u32 s18, 16
    s_cbranch_scc0 L_loop
    s_lshl_b32 s25, s21, 13
    v_add_u32 v7, s25, v5
    ds_write_b128 v7, v[8:11] offset:0
    ds_write_b128 v7, v[12:15] offset:1024
    ds_write_b128 v7, v[16:19] offset:2048
    ds_write_b128 v7, v[20:23] offset:3072
    ds_write_b128 v7, v[24:27] offset:4096
    ds_write_b128 v7, v[28:31] offset:5120
    ds_write_b128 v7, v[32:35] offset:6144
    ds_write_b128 v7, v[36:39] offset:7168
    s_waitcnt lgkmcnt(0)
    v_mov_b32 v8, 0
    v_mov_b32 v9, 0
    v_mov_b32 v10, 0
    v_mov_b32 v11, 0
    v_mov_b32 v12, 0
    v_mov_b32 v13, 0
    v_mov_b32 v14, 0
    v_mov_b32 v15, 0
    v_mov_b32 v16, 0
    v_mov_b32 v17, 0
    v_mov_b32 v18, 0
    v_mov_b32 v19, 0
    v_mov_b32 v20, 0
    v_mov_b32 v21, 0
    v_mov_b32 v22, 0
    v_mov_b32 v23, 0
    v_mov_b32 v24, 0
    v_mov_b32 v25, 0
    v_mov_b32 v26, 0
    v_mov_b32 v27, 0
    v_mov_b32 v28, 0
    v_mov_b32 v29, 0
    v_mov_b32 v30, 0
    v_mov_b32 v31, 0
    v_mov_b32 v32, 0
    v_mov_b32 v33, 0
    v_mov_b32 v34, 0
    v_mov_b32 v35, 0
    v_mov_b32 v36, 0
    v_mov_b32 v37, 0
    v_mov_b32 v38, 0
    v_mov_b32 v39, 0
    s_branch L_loop
L_switch:
    s_add_u32 s4, s32, s23
    s_addc_u32 s5, s33, 0
    s_mov_b64 s[8:9], s[36:37]
    s_xor_b32 s49, s49, 524288
    s_lshr_b32 s53, s49, 7
    v_xor_b32 v62, 524288, v62
    s_cmp_eq_u32 s18, 31
    s_cbranch_scc0 L_swret
    s_mov_b32 s6, 0
    s_mov_b32 s10, 0
    s_mov_b32 s27, 0
    s_mov_b32 s22, 0
    s_branch L_swret
L_tail:
    v_lshrrev_b32 v7, 1, v5
    ds_read_b64 v[56:57], v7 offset:24576
    s_waitcnt vmcnt(24)
    v_perm_b32 v138, v192, v188, s16
    v_perm_b32 v142, v192, v188, s17
    v_perm_b32 v146, v193, v189, s16
    v_perm_b32 v150, v193, v189, s17
    v_perm_b32 v154, v194, v190, s16
    v_perm_b32 v158, v194, v190, s17
    v_perm_b32 v162, v195, v191, s16
    v_perm_b32 v166, v195, v191, s17
    s_waitcnt vmcnt(22)
    v_perm_b32 v139, v200, v196, s16
    v_perm_b32 v143, v200, v196, s17
    v_perm_b32 v147, v201, v197, s16
    v_perm_b32 v151, v201, v197, s17
    v_perm_b32 v155, v202, v198, s16
    v_perm_b32 v159, v202, v198, s17
    v_perm_b32 v163, v203, v199, s16
    v_perm_b32 v167, v203, v199, s17
    s_waitcnt vmcnt(20)
    v_perm_b32 v136, v176, v172, s16
    v_perm_b32 v140, v176, v172, s17
    v_perm_b32 v144, v177, v173, s16
    v_perm_b32 v148, v177, v173, s17
    v_perm_b32 v152, v178, v174, s16
    v_perm_b32 v156, v178, v174, s17
    v_perm_b32 v160, v179, v175, s16
    v_perm_b32 v164, v179, v175, s17
    s_waitcnt vmcnt(18)
    v_perm_b32 v137, v184, v180, s16
    v_perm_b32 v141, v184, v180, s17
    v_perm_b32 v145, v185, v181, s16
    v_perm_b32 v149, v185, v181, s17
    v_perm_b32 v153, v186, v182, s16
    v_perm_b32 v157, v186, v182, s17
    v_perm_b32 v161, v187, v183, s16
    v_perm_b32 v165, v187, v183, s17
    s_cmp_eq_u32 s21, 0
    s_cbranch_scc1 L_ep0
L_ep1:
    v_mfma_f32_16x16x32_bf16 v[8:11], v[204:207], v[136:139], v[8:11]
    v_mfma_f32_16x16x32_bf16 v[12:15], v[204:207], v[140:143], v[12:15]
    v_mfma_f32_16x16x32_bf16 v[16:19], v[204:207], v[144:147], v[16:19]
    v_mfma_f32_16x16x32_bf16 v[20:23], v[204:207], v[148:151], v[20:23]
    v_mfma_f32_16x16x32_bf16 v[24:27], v[204:207], v[152:155], v[24:27]
    v_mfma_f32_16x16x32_bf16 v[28:31], v[204:207], v[156:159], v[28:31]
    v_mfma_f32_16x16x32_bf16 v[32:35], v[204:207], v[160:163], v[32:35]
    v_mfma_f32_16x16x32_bf16 v[36:39], v[204:207], v[164:167], v[36:39]
    s_nop 0
    ds_write_b128 v5, v[8:11] offset:20480
    ds_write_b128 v5, v[12:15] offset:21504
    ds_write_b128 v5, v[16:19] offset:22528
    ds_write_b128 v5, v[20:23] offset:23552
    s_waitcnt lgkmcnt(0)
    s_barrier
    ds_read_b128 v[40:43], v5 offset:16384
    ds_read_b128 v[44:47], v5 offset:17408
    ds_read_b128 v[48:51], v5 offset:18432
    ds_read_b128 v[52:55], v5 offset:19456
    s_waitcnt lgkmcnt(3)
    v_pk_add_f32 v[40:41], v[24:25], v[40:41]
    v_pk_add_f32 v[42:43], v[26:27], v[42:43]
    v_cvt_pk_bf16_f32 v172, v40, v41
    v_cvt_pk_bf16_f32 v173, v42, v43
    s_waitcnt lgkmcnt(2)
    v_pk_add_f32 v[44:45], v[28:29], v[44:45]
    v_pk_add_f32 v[46:47], v[30:31], v[46:47]
    v_mfma_f32_16x16x16_bf16 v[180:183], v[56:57], v[172:173], 0
    v_cvt_pk_bf16_f32 v174, v44, v45
    v_cvt_pk_bf16_f32 v175, v46, v47
    s_waitcnt lgkmcnt(1)
    v_pk_add_f32 v[48:49], v[32:33], v[48:49]
    v_pk_add_f32 v[50:51], v[34:35], v[50:51]
    v_mfma_f32_16x16x16_bf16 v[184:187], v[56:57], v[174:175], 0
    v_cvt_pk_bf16_f32 v176, v48, v49
    v_cvt_pk_bf16_f32 v177, v50, v51
    s_waitcnt lgkmcnt(0)
    v_pk_add_f32 v[52:53], v[36:37], v[52:53]
    v_pk_add_f32 v[54:55], v[38:39], v[54:55]
    v_mfma_f32_16x16x16_bf16 v[188:191], v[56:57], v[176:177], 0
    v_cvt_pk_bf16_f32 v178, v52, v53
    v_cvt_pk_bf16_f32 v179, v54, v55
    s_branch L_ep2
L_ep0:
    v_mfma_f32_16x16x32_bf16 v[24:27], v[204:207], v[152:155], v[24:27]
    v_mfma_f32_16x16x32_bf16 v[28:31], v[204:207], v[156:159], v[28:31]
    v_mfma_f32_16x16x32_bf16 v[32:35], v[204:207], v[160:163], v[32:35]
    v_mfma_f32_16x16x32_bf16 v[36:39], v[204:207], v[164:167], v[36:39]
    v_mfma_f32_16x16x32_bf16 v[8:11], v[204:207], v[136:139], v[8:11]
    v_mfma_f32_16x16x32_bf16 v[12:15], v[204:207], v[140:143], v[12:15]
    v_mfma_f32_16x16x32_bf16 v[16:19], v[204:207], v[144:147], v[16:19]
    v_mfma_f32_16x16x32_bf16 v[20:23], v[204:207], v[148:151], v[20:23]
    s_nop 0
    ds_write_b128 v5, v[24:27] offset:16384
    ds_write_b128 v5, v[28:31] offset:17408
    ds_write_b128 v5, v[32:35] offset:18432
    ds_write_b128 v5, v[36:39] offset:19456
    s_waitcnt lgkmcnt(0)
    s_barrier
    ds_read_b128 v[40:43], v5 offset:20480
    ds_read_b128 v[44:47], v5 offset:21504
    ds_read_b128 v[48:51], v5 offset:22528
    ds_read_b128 v[52:55], v5 offset:23552
    s_waitcnt lgkmcnt(3)
    v_pk_add_f32 v[40:41], v[8:9], v[40:41]
    v_pk_add_f32 v[42:43], v[10:11], v[42:43]
    v_cvt_pk_bf16_f32 v172, v40, v41
    v_cvt_pk_bf16_f32 v173, v42, v43
    s_waitcnt lgkmcnt(2)
    v_pk_add_f32 v[44:45], v[12:13], v[44:45]
    v_pk_add_f32 v[46:47], v[14:15], v[46:47]
    v_mfma_f32_16x16x16_bf16 v[180:183], v[56:57], v[172:173], 0
    v_cvt_pk_bf16_f32 v174, v44, v45
    v_cvt_pk_bf16_f32 v175, v46, v47
    s_waitcnt lgkmcnt(1)
    v_pk_add_f32 v[48:49], v[16:17], v[48:49]
    v_pk_add_f32 v[50:51], v[18:19], v[50:51]
    v_mfma_f32_16x16x16_bf16 v[184:187], v[56:57], v[174:175], 0
    v_cvt_pk_bf16_f32 v176, v48, v49
    v_cvt_pk_bf16_f32 v177, v50, v51
    s_waitcnt lgkmcnt(0)
    v_pk_add_f32 v[52:53], v[20:21], v[52:53]
    v_pk_add_f32 v[54:55], v[22:23], v[54:55]
    v_mfma_f32_16x16x16_bf16 v[188:191], v[56:57], v[176:177], 0
    v_cvt_pk_bf16_f32 v178, v52, v53
    v_cvt_pk_bf16_f32 v179, v54, v55
L_ep2:
    s_nop 1
    v_mfma_f32_16x16x16_bf16 v[192:195], v[56:57], v[178:179], 0
    s_nop 2
    v_cvt_pk_bf16_f32 v196, v180, v184
    v_cvt_pk_bf16_f32 v198, v181, v185
    v_cvt_pk_bf16_f32 v200, v182, v186
    v_cvt_pk_bf16_f32 v202, v183, v187
    s_nop 0
    v_cvt_pk_bf16_f32 v197, v188, v192
    buffer_store_dwordx2 v[196:197], v6, s[12:15], 0 offen
    v_cvt_pk_bf16_f32 v199, v189, v193
    buffer_store_dwordx2 v[198:199], v6, s[12:15], 0 offen offset:256
    v_cvt_pk_bf16_f32 v201, v190, v194
    buffer_store_dwordx2 v[200:201], v6, s[12:15], 0 offen offset:512
    v_cvt_pk_bf16_f32 v203, v191, v195
    buffer_store_dwordx2 v[202:203], v6, s[12:15], 0 offen offset:768
L_end:
    s_endpgm
L_helper:
    s_memrealtime s[44:45]
    v_and_b32 v5, 63, v0
    v_mov_b32 v59, 0
    v_mov_b32 v100, 0
    ds_write_b32 v59, v100 offset:25088
    s_waitcnt lgkmcnt(0)
    s_mov_b64 s[8:9], s[34:35]
    s_lshr_b32 s25, s2, 3
    s_lshl_b32 s25, s25, 12
    v_lshlrev_b32 v7, 4, v5
    buffer_load_dwordx4 v[64:67], v7, s[8:11], s25 offen offset:0
    buffer_load_dwordx4 v[68:71], v7, s[8:11], s25 offen offset:1024
    buffer_load_dwordx4 v[72:75], v7, s[8:11], s25 offen offset:2048
    buffer_load_dwordx4 v[76:79], v7, s[8:11], s25 offen offset:3072
    s_mov_b64 s[8:9], s[36:37]
    s_lshr_b32 s25, s2, 3
    s_lshl_b32 s25, s25, 12
    v_and_b32 v7, 63, v0
    v_lshlrev_b32 v7, 4, v7
    buffer_load_dwordx4 v[80:83], v7, s[8:11], s25 offen offset:0
    buffer_load_dwordx4 v[84:87], v7, s[8:11], s25 offen offset:1024
    buffer_load_dwordx4 v[88:91], v7, s[8:11], s25 offen offset:2048
    buffer_load_dwordx4 v[92:95], v7, s[8:11], s25 offen offset:3072
    s_add_u32 s12, s28, s24
    s_addc_u32 s13, s29, 0
    s_mov_b32 s14, 2048
    s_mov_b32 s15, 0x20000
    v_lshlrev_b32 v7, 8, v3
    v_lshl_add_u32 v7, v4, 4, v7
    buffer_load_dwordx4 v[8:11], v7, s[12:15], 0 offen
    buffer_load_dwordx4 v[12:15], v7, s[12:15], 0 offen offset:64
    buffer_load_dwordx4 v[16:19], v7, s[12:15], 0 offen offset:128
    buffer_load_dwordx4 v[20:23], v7, s[12:15], 0 offen offset:192
    v_lshrrev_b32 v6, 2, v3
    v_lshlrev_b32 v6, 8, v6
    v_lshl_add_u32 v6, v4, 4, v6
    v_and_b32 v7, 3, v3
    v_lshl_add_u32 v6, v7, 2, v6
    s_mov_b32 s49, 0x3db504f3
    s_mov_b32 s53, 0x3fb8aa3b
    s_add_u32 s76, s42, 0x100000
    s_addc_u32 s77, s43, 0
    s_mov_b32 s78, 0x40000
    s_mov_b32 s79, 0x20000
    s_and_b32 s22, s2, 0x78
    s_lshr_b32 s25, s2, 4
    s_and_b32 s25, s25, 8
    s_and_b32 s26, s2, 7
    s_or_b32 s25, s25, s26
    s_lshl_b32 s25, s25, 8
    v_lshlrev_b32 v99, 2, v5
    v_and_b32 v99, 127, v99
    v_add_u32 v99, s25, v99
    v_and_b32 v98, 15, v3
    v_lshlrev_b32 v98, 8, v98
    v_lshlrev_b32 v101, 3, v5
    v_lshlrev_b32 v5, 4, v5
    s_sub_u32 s18, s44, 300
    s_mov_b32 s19, 0
    s_mov_b32 s20, 0
    s_mov_b32 s27, 0
    s_mov_b32 s16, 0
    s_mov_b32 s3, 0
    s_mov_b32 s48, 0
    s_mov_b32 s66, 0
    s_mov_b32 s67, 0
    s_mov_b32 s68, 0
    s_mov_b32 s17, 0
L_h:
    s_barrier
    s_memrealtime s[44:45]
    s_cmp_eq_u32 s17, 0
    s_cbranch_scc1 L_noproc
    s_getreg_b32 s25, hwreg(HW_REG_IB_STS, 0, 4)
    s_cmp_lg_u32 s25, 0
    s_cbranch_scc1 L_noproc
    s_waitcnt vmcnt(0)
    v_subrev_u32 v97, s18, v96
    v_cmp_gt_u32 vcc, 0x8000, v97
    v_mov_b32 v100, s67
    s_sub_u32 s65, s16, s17
    v_cndmask_b32 v97, v100, v97, vcc
    s_nop 1
    v_add_u32_dpp v97, v97, v97 row_ror:1 row_mask:0xf bank_mask:0xf
    s_nop 1
    v_add_u32_dpp v97, v97, v97 row_ror:2 row_mask:0xf bank_mask:0xf
    s_nop 1
    v_add_u32_dpp v97, v97, v97 row_ror:4 row_mask:0xf bank_mask:0xf
    s_nop 1
    v_add_u32_dpp v97, v97, v97 row_ror:8 row_mask:0xf bank_mask:0xf
    v_lshlrev_b32 v97, 2, v97
    s_nop 0
    v_readfirstlane_b32 s25, v97
    s_cmp_eq_u32 vcc_lo, -1
    s_cbranch_scc1 L_valid
    s_mov_b32 s17, 0
    s_cmp_lg_u32 s19, 0
    s_cselect_b32 s3, 2, 0
    s_cselect_b32 s26, s68, 0
    s_mov_b32 s68, 1
    s_cmp_eq_u32 s26, 0
    s_cbranch_scc1 L_noproc
    s_branch L_setp
L_valid:
    s_mov_b32 s68, 0
    s_mov_b32 s17, 0
    s_mul_i32 s26, s65, s19
    s_add_u32 s26, s26, s25
    s_sub_u32 s26, s26, s27
    s_cmp_lt_u32 s3, 2
    s_cbranch_scc1 L_seed
    s_cmp_lt_i32 s26, -1920
    s_cbranch_scc1 L_seed
    s_min_i32 s26, s26, 2560
    s_ashr_i32 s26, s26, 2
L_seed:
    s_ashr_i32 s26, s26, 3
    s_cmp_eq_u32 s3, 0
    s_cselect_b32 s26, s20, s26
    s_add_u32 s19, s19, s26
    s_add_u32 s3, s3, 1
L_setp:
    s_mul_i32 s27, s65, s19
    s_add_u32 s27, s27, s25
L_noproc:
    s_waitcnt lgkmcnt(0)
    s_sub_u32 s25, s16, 8
    s_cmp_gt_u32 s25, 109
    s_cbranch_scc1 L_hq
    s_and_b32 s21, s25, 7
    s_cmp_lg_u32 s21, 0
    s_cbranch_scc1 L_nopub
    s_mov_b32 s66, s44
    s_cmp_lg_u32 s25, 0
    s_cbranch_scc1 L_no0
    s_waitcnt vmcnt(0)
L_no0:
    s_cmp_lg_u32 s22, 0
    s_cbranch_scc1 L_hq
    v_mov_b32 v100, s44
    s_lshl_b32 s25, s16, 10
    buffer_store_dword v100, v99, s[76:79], s25 offen sc1
    s_branch L_hq
L_nopub:
    s_cmp_lg_u32 s21, 5
    s_cbranch_scc1 L_hq
    s_cmp_lg_u32 s17, 0
    s_cbranch_scc1 L_hq
    s_sub_u32 s17, s16, 5
    s_lshl_b32 s25, s17, 10
    s_sub_u32 s67, s44, s18
    s_sub_u32 s20, s44, s66
    s_mul_i32 s20, s20, 3277
    s_lshr_b32 s20, s20, 8
    s_cmp_lg_u32 s68, 0
    s_cbranch_scc1 L_fresh
    buffer_load_dword v96, v98, s[76:79], s25 offen
    s_branch L_hq
L_fresh:
    buffer_load_dword v96, v98, s[76:79], s25 offen sc1
L_hq:
    s_sub_u32 s25, s44, s18
    s_lshl_b32 s25, s25, 6
    s_sub_u32 s25, s27, s25
    s_add_u32 s27, s27, s19
    s_max_i32 s25, s25, -6400
    s_min_i32 s25, s25, 3840
    s_mul_i32 s25, s25, 41
    s_cmp_eq_u32 s19, 0
    s_cselect_b32 s25, 0, s25
    s_add_u32 s25, s25, 344064
    s_max_i32 s25, s25, 65536
    s_add_u32 s48, s48, s25
    s_lshr_b32 s25, s48, 16
    s_and_b32 s48, s48, 0xffff
    s_cmp_lt_u32 s16, 3
    s_cselect_b32 s25, 0, s25
    v_mov_b32 v100, s25
    ds_write_b32 v59, v100 offset:25088
    s_add_u32 s16, s16, 1
    s_cmp_eq_u32 s16, 124
    s_cbranch_scc1 L_end
    s_sub_u32 s25, s16, 66
    s_cmp_gt_u32 s25, 5
    s_cbranch_scc1 L_h
    s_cmp_lg_u32 s25, 0
    s_cbranch_scc1 L_k0
    ds_read2st64_b32 v[64:65], v6 offset0:0 offset1:4
    ds_read2st64_b32 v[66:67], v6 offset0:8 offset1:12
    ds_read2st64_b32 v[68:69], v6 offset0:16 offset1:20
    ds_read2st64_b32 v[70:71], v6 offset0:24 offset1:28
    ds_read2st64_b32 v[72:73], v6 offset0:32 offset1:36
    ds_read2st64_b32 v[74:75], v6 offset0:40 offset1:44
    ds_read2st64_b32 v[76:77], v6 offset0:48 offset1:52
    ds_read2st64_b32 v[78:79], v6 offset0:56 offset1:60
    v_add_u32 v6, 64, v6
    s_waitcnt lgkmcnt(0)
    v_add_f32 v64, v64, v72
    v_add_f32 v65, v65, v73
    v_add_f32 v66, v66, v74
    v_add_f32 v67, v67, v75
    v_add_f32 v68, v68, v76
    v_add_f32 v69, v69, v77
    v_add_f32 v70, v70, v78
    v_add_f32 v71, v71, v79
    v_cvt_pk_bf16_f32 v40, v64, v65
    v_cvt_pk_bf16_f32 v41, v66, v67
    v_cvt_pk_bf16_f32 v42, v68, v69
    v_cvt_pk_bf16_f32 v43, v70, v71
    s_branch L_h
L_k0:
    s_cmp_lg_u32 s25, 1
    s_cbranch_scc1 L_k1
    ds_read2st64_b32 v[64:65], v6 offset0:0 offset1:4
    ds_read2st64_b32 v[66:67], v6 offset0:8 offset1:12
    ds_read2st64_b32 v[68:69], v6 offset0:16 offset1:20
    ds_read2st64_b32 v[70:71], v6 offset0:24 offset1:28
    ds_read2st64_b32 v[72:73], v6 offset0:32 offset1:36
    ds_read2st64_b32 v[74:75], v6 offset0:40 offset1:44
    ds_read2st64_b32 v[76:77], v6 offset0:48 offset1:52
    ds_read2st64_b32 v[78:79], v6 offset0:56 offset1:60
    v_add_u32 v6, 64, v6
    s_waitcnt lgkmcnt(0)
    v_add_f32 v64, v64, v72
    v_add_f32 v65, v65, v73
    v_add_f32 v66, v66, v74
    v_add_f32 v67, v67, v75
    v_add_f32 v68, v68, v76
    v_add_f32 v69, v69, v77
    v_add_f32 v70, v70, v78
    v_add_f32 v71, v71, v79
    v_cvt_pk_bf16_f32 v44, v64, v65
    v_cvt_pk_bf16_f32 v45, v66, v67
    v_cvt_pk_bf16_f32 v46, v68, v69
    v_cvt_pk_bf16_f32 v47, v70, v71
    s_branch L_h
L_k1:
    s_cmp_lg_u32 s25, 2
    s_cbranch_scc1 L_k2
    ds_read2st64_b32 v[64:65], v6 offset0:0 offset1:4
    ds_read2st64_b32 v[66:67], v6 offset0:8 offset1:12
    ds_read2st64_b32 v[68:69], v6 offset0:16 offset1:20
    ds_read2st64_b32 v[70:71], v6 offset0:24 offset1:28
    ds_read2st64_b32 v[72:73], v6 offset0:32 offset1:36
    ds_read2st64_b32 v[74:75], v6 offset0:40 offset1:44
    ds_read2st64_b32 v[76:77], v6 offset0:48 offset1:52
    ds_read2st64_b32 v[78:79], v6 offset0:56 offset1:60
    v_add_u32 v6, 64, v6
    s_waitcnt lgkmcnt(0)
    v_add_f32 v64, v64, v72
    v_add_f32 v65, v65, v73
    v_add_f32 v66, v66, v74
    v_add_f32 v67, v67, v75
    v_add_f32 v68, v68, v76
    v_add_f32 v69, v69, v77
    v_add_f32 v70, v70, v78
    v_add_f32 v71, v71, v79
    v_cvt_pk_bf16_f32 v48, v64, v65
    v_cvt_pk_bf16_f32 v49, v66, v67
    v_cvt_pk_bf16_f32 v50, v68, v69
    v_cvt_pk_bf16_f32 v51, v70, v71
    s_branch L_h
L_k2:
    s_cmp_lg_u32 s25, 4
    s_cbranch_scc1 L_k3
    ds_read2st64_b32 v[64:65], v6 offset0:0 offset1:4
    ds_read2st64_b32 v[66:67], v6 offset0:8 offset1:12
    ds_read2st64_b32 v[68:69], v6 offset0:16 offset1:20
    ds_read2st64_b32 v[70:71], v6 offset0:24 offset1:28
    ds_read2st64_b32 v[72:73], v6 offset0:32 offset1:36
    ds_read2st64_b32 v[74:75], v6 offset0:40 offset1:44
    ds_read2st64_b32 v[76:77], v6 offset0:48 offset1:52
    ds_read2st64_b32 v[78:79], v6 offset0:56 offset1:60
    v_add_u32 v6, 64, v6
    s_waitcnt lgkmcnt(0)
    v_add_f32 v64, v64, v72
    v_add_f32 v65, v65, v73
    v_add_f32 v66, v66, v74
    v_add_f32 v67, v67, v75
    v_add_f32 v68, v68, v76
    v_add_f32 v69, v69, v77
    v_add_f32 v70, v70, v78
    v_add_f32 v71, v71, v79
    v_cvt_pk_bf16_f32 v52, v64, v65
    v_cvt_pk_bf16_f32 v53, v66, v67
    v_cvt_pk_bf16_f32 v54, v68, v69
    v_cvt_pk_bf16_f32 v55, v70, v71
    s_branch L_h
L_k3:
    s_cmp_lg_u32 s25, 5
    s_cbranch_scc1 L_h
    v_mfma_f32_16x16x32_bf16 v[24:27], v[40:43], v[8:11], 0
    v_mfma_f32_16x16x32_bf16 v[24:27], v[44:47], v[12:15], v[24:27]
    v_mfma_f32_16x16x32_bf16 v[24:27], v[48:51], v[16:19], v[24:27]
    v_mfma_f32_16x16x32_bf16 v[24:27], v[52:55], v[20:23], v[24:27]
    s_nop 7
    s_nop 1
    v_cvt_pk_bf16_f32 v28, v24, v25
    v_cvt_pk_bf16_f32 v29, v26, v27
    v_lshlrev_b32 v24, 16, v28
    v_and_b32 v25, 0xffff0000, v28
    v_lshlrev_b32 v26, 16, v29
    v_and_b32 v27, 0xffff0000, v29
    v_mul_f32 v24, s49, v24
    v_mul_f32 v25, s49, v25
    v_mul_f32 v26, s49, v26
    v_mul_f32 v27, s49, v27
    v_cvt_pk_bf16_f32 v28, v24, v25
    v_cvt_pk_bf16_f32 v29, v26, v27
    v_lshlrev_b32 v24, 16, v28
    v_and_b32 v25, 0xffff0000, v28
    v_lshlrev_b32 v26, 16, v29
    v_and_b32 v27, 0xffff0000, v29
    v_max3_f32 v30, v24, v25, v26
    v_max_f32 v30, v30, v27
    v_mov_b32 v31, v30
    s_nop 1
    v_permlane16_swap_b32 v30, v31
    s_nop 1
    v_max_f32 v30, v30, v31
    v_mov_b32 v31, v30
    s_nop 1
    v_permlane32_swap_b32 v30, v31
    s_nop 1
    v_max_f32 v30, v30, v31
    v_sub_f32 v24, v24, v30
    v_sub_f32 v25, v25, v30
    v_sub_f32 v26, v26, v30
    v_sub_f32 v27, v27, v30
    v_mul_f32 v24, s53, v24
    v_mul_f32 v25, s53, v25
    v_mul_f32 v26, s53, v26
    v_mul_f32 v27, s53, v27
    v_exp_f32 v24, v24
    v_exp_f32 v25, v25
    v_exp_f32 v26, v26
    v_exp_f32 v27, v27
    s_nop 0
    v_add_f32 v30, v24, v25
    v_add_f32 v31, v26, v27
    v_add_f32 v30, v30, v31
    v_mov_b32 v31, v30
    s_nop 1
    v_permlane16_swap_b32 v30, v31
    s_nop 1
    v_add_f32 v30, v30, v31
    v_mov_b32 v31, v30
    s_nop 1
    v_permlane32_swap_b32 v30, v31
    s_nop 1
    v_add_f32 v30, v30, v31
    v_rcp_f32 v30, v30
    s_nop 0
    v_mul_f32 v24, v24, v30
    v_mul_f32 v25, v25, v30
    v_mul_f32 v26, v26, v30
    v_mul_f32 v27, v27, v30
    v_cvt_pk_bf16_f32 v28, v24, v25
    v_cvt_pk_bf16_f32 v29, v26, v27
    ds_write_b64 v101, v[28:29] offset:24576
    s_waitcnt lgkmcnt(0)
    s_branch L_h
L_codeend:
.section .rodata,"a"
.p2align 6
.amdhsa_kernel standalone__low_rank_proj_linformer__sampling_kernel
  .amdhsa_next_free_vgpr 208
  .amdhsa_next_free_sgpr 80
  .amdhsa_accum_offset 208
  .amdhsa_group_segment_fixed_size 0
  .amdhsa_kernarg_size 64
  .amdhsa_user_sgpr_count 2
  .amdhsa_user_sgpr_kernarg_segment_ptr 1
  .amdhsa_system_sgpr_workgroup_id_x 1
.end_amdhsa_kernel
```
